```python
import torch

def _softmax(x, axis=-1):
    return torch.softmax(x, dim=axis)
def _gelu(x):
    return torch.nn.functional.gelu(x, approximate="tanh")
def _silu(x):
    return torch.nn.functional.silu(x)
def _sigmoid(x):
    return torch.sigmoid(x)
def _layernorm(x, axis=-1, eps=1e-5):
    m = x.mean(dim=axis, keepdim=True)
    v = x.var(dim=axis, keepdim=True, unbiased=False)
    return (x - m) / torch.sqrt(v + eps)
def _scatter_add(tgt, idx, src, axis=0):
    return tgt.clone().index_add_(axis, idx, src)
def _segment_sum(src, seg, n):
    out = torch.zeros((n,) + src.shape[1:], dtype=src.dtype)
    return out.index_add_(0, seg, src)
def _pad(x, pw):
    flat = tuple(v for pair in reversed(pw) for v in pair)
    return torch.nn.functional.pad(x, flat)

kernel_name = 'standalone__paged_block_table_kv_pagedattention__decode'

def setup_inputs():

    _w = (lambda a: (lambda t: t.to(torch.bfloat16) if t.is_floating_point() else t)(torch.as_tensor(a)))
    B, Hq, Hkv, Sq, Skv, D = 2, 32, 4, 1, 32768, 128
    bs = 16
    nbps = max(1, Skv // bs)
    num_phys = B * nbps + 4
    bt = torch.randperm(num_phys)[: B * nbps].reshape(B, nbps).to(torch.int64)
    cl = (nbps * bs - (torch.arange(1, B + 1, dtype=torch.int64) * 2654435761) % max(1, nbps * bs // 2)).to(torch.int64)
    return {
        "q": _w((lambda *s: torch.randn(*s, dtype=torch.bfloat16) * 0.8)(B, Hq, Sq, D)),
        "k_cache": _w((lambda *s: torch.randn(*s, dtype=torch.bfloat16) * 0.8)(num_phys, bs, Hkv, D)),
        "v_cache": _w((lambda *s: torch.randn(*s, dtype=torch.bfloat16) * 0.05)(num_phys, bs, Hkv, D)),
        "block_table": _w(bt),
        "context_lens": _w(cl),
    }

def reference(q, k_cache, v_cache, block_table, context_lens):
    B, Hq, Sq, D = q.shape
    bs = k_cache.shape[1]
    Hkv = k_cache.shape[2]
    nbps = block_table.shape[1]
    Skv = nbps * bs
    bt = block_table.reshape(-1)
    k = (lambda x, *d: x.permute(*d))(k_cache[bt].reshape(B, Skv, Hkv, D), 0, 2, 1, 3)
    v = (lambda x, *d: x.permute(*d))(v_cache[bt].reshape(B, Skv, Hkv, D), 0, 2, 1, 3)
    g = Hq // Hkv
    qg = q.reshape(B, Hkv, g, Sq, D)
    scores = torch.einsum("bhgqd,bhkd->bhgqk", qg, k) * (D ** -0.5)
    pos = torch.arange(Skv)
    msk = pos[None, :] < context_lens[:, None]
    scores = torch.where(msk[:, None, None, None, :], scores, -1e9)
    p = _softmax(scores, axis=-1)
    out = torch.einsum("bhgqk,bhkd->bhgqd", p, v)
    return out.reshape(B, Hq, Sq, D)
```

```asm
; @launch grid=(256,1,1) block=(256,1,1) lds=102032
.amdgcn_target "amdgcn-amd-amdhsa--gfx950"
.text
.globl standalone__paged_block_table_kv_pagedattention__decode_kernel
.p2align 8
.type standalone__paged_block_table_kv_pagedattention__decode_kernel,@function
standalone__paged_block_table_kv_pagedattention__decode_kernel:
    s_load_dwordx16 s[4:19], s[0:1], 0
    s_memrealtime s[84:85]
    v_lshrrev_b32 v1, 6, v0
    s_cmp_ge_u32 s2, 256
    s_cbranch_scc1 L_end
    v_readfirstlane_b32 s3, v1
    s_lshr_b32 s81, s2, 1
    s_movk_i32 s44, 61
    s_mov_b32 s42, 604462
    s_mov_b32 s43, 599727
    s_movk_i32 s98, 17999
    s_movk_i32 s99, 19614
    s_and_b32 s80, s3, 1
    s_lshl_b32 s62, s80, 15
L_ranges:
    s_cmp_ge_u32 s81, s44
    s_cselect_b32 s45, 0x800, 0
    s_cselect_b32 s60, s44, 0
    s_cselect_b32 s48, s43, s42
    s_cselect_b32 s49, s99, s98
    s_sub_u32 s60, s81, s60
    s_lshr_b32 s61, s3, 1
    s_lshl1_add_u32 s60, s60, s61
    s_mul_i32 s60, s60, s48
    s_add_u32 s61, s60, s62
    s_lshr_b32 s50, s61, 16
    s_add_u32 s59, s45, s50
    s_min_u32 s60, s59, 4080
    s_lshl_b32 s86, s60, 2
    s_waitcnt lgkmcnt(0)
    s_load_dwordx16 s[64:79], s[10:11], s86
    s_load_dwordx2 s[40:41], s[12:13], 0
    s_sub_u32 s52, s59, s60
    s_add_u32 s61, s61, s48
    s_lshr_b32 s51, s61, 16
    s_sub_u32 s51, s51, s50
    v_and_b32 v0, 63, v0
    v_lshrrev_b32 v1, 4, v0
    v_and_b32 v2, 15, v0
    s_and_b32 s82, s2, 1
    s_and_b32 s80, s3, 1
    s_lshl1_add_u32 s80, s82, s80
    v_mov_b32 v181, 0
    s_mov_b32 s32, s16
    s_mov_b32 s33, s17
    s_mov_b32 s34, 256
    s_mov_b32 s35, 0x00020000
    s_or_b32 s83, s2, s3
    s_cmp_lg_u32 s83, 0
    s_cbranch_scc1 L_nononce
    s_or_b32 s60, s84, 1
    s_or_b32 s61, s85, 0x80000000
    v_mov_b32 v56, s60
    v_mov_b32 v57, s61
    s_mov_b64 exec, 1
    buffer_store_dwordx2 v[56:57], v181, s[32:35], 0 offen sc1
    s_mov_b64 exec, -1
L_nononce:
    v_and_b32 v61, 7, v2
    v_lshlrev_b32 v61, 8, v61
    v_lshl_add_u32 v61, v1, 6, v61
    s_lshl_b32 s59, s45, 2
    s_lshl_b32 s60, s80, 11
    s_add_u32 s59, s59, s60
    s_mov_b32 s24, s4
    s_mov_b32 s25, s5
    s_mov_b32 s26, 16384
    s_mov_b32 s27, 0x00020000
    buffer_load_dwordx4 v[16:19], v61, s[24:27], s59 offen offset:0
    buffer_load_dwordx4 v[20:23], v61, s[24:27], s59 offen offset:16
    buffer_load_dwordx4 v[24:27], v61, s[24:27], s59 offen offset:32
    buffer_load_dwordx4 v[28:31], v61, s[24:27], s59 offen offset:48
    v_and_b32 v58, 1, v1
    v_lshrrev_b32 v59, 1, v1
    v_lshl_add_u32 v3, v58, 3, v59
    v_xor_b32 v58, v2, v3
    v_lshlrev_b32 v58, 4, v58
    v_lshl_add_u32 v58, v1, 12, v58
    s_lshl_b32 s60, s80, 8
    v_add_u32 v4, s60, v58
    v_xor_b32 v5, 32, v4
    v_xor_b32 v6, 64, v4
    v_xor_b32 v7, 0x60, v4
    s_mul_i32 s57, s3, 16384
    s_add_u32 s58, s57, 16384
    s_mov_b32 s20, s6
    s_mov_b32 s21, s7
    s_mov_b32 s22, 67174400
    s_mov_b32 s23, 0x00020000
    s_lshl_b32 s54, s51, 1
    s_mov_b32 s53, 0
    s_mov_b32 s55, s57
    s_cmp_gt_u32 s51, 4
    s_cselect_b32 s63, 1, 0
    s_cmp_eq_u32 s52, 0
    s_cselect_b32 s63, s63, 0
    s_mov_b32 m0, s57
    s_waitcnt lgkmcnt(0)
    s_cmp_eq_u64 s[40:41], s[98:99]
    s_cbranch_scc0 L_general
    s_cmp_eq_u32 s63, 0
    s_cbranch_scc1 L_slowpro
    s_lshl_b32 s60, s64, 14
    buffer_load_dwordx4 v4, s[20:23], s60 offen offset:0 nt lds
    buffer_load_dwordx4 v5, s[20:23], s60 offen offset:1024 nt lds
    buffer_load_dwordx4 v6, s[20:23], s60 offen offset:2048 nt lds
    buffer_load_dwordx4 v7, s[20:23], s60 offen offset:3072 nt lds
    s_lshl_b32 s60, s65, 14
    s_add_u32 m0, s57, 4096
    s_nop 0
    buffer_load_dwordx4 v4, s[20:23], s60 offen offset:0 nt lds
    buffer_load_dwordx4 v5, s[20:23], s60 offen offset:1024 nt lds
    buffer_load_dwordx4 v6, s[20:23], s60 offen offset:2048 nt lds
    buffer_load_dwordx4 v7, s[20:23], s60 offen offset:3072 nt lds
    s_lshl_b32 s60, s66, 14
    s_add_u32 m0, s57, 8192
    s_nop 0
    buffer_load_dwordx4 v4, s[20:23], s60 offen offset:0 nt lds
    buffer_load_dwordx4 v5, s[20:23], s60 offen offset:1024 nt lds
    buffer_load_dwordx4 v6, s[20:23], s60 offen offset:2048 nt lds
    buffer_load_dwordx4 v7, s[20:23], s60 offen offset:3072 nt lds
    s_lshl_b32 s60, s67, 14
    s_add_u32 m0, s57, 12288
    s_nop 0
    buffer_load_dwordx4 v4, s[20:23], s60 offen offset:0 nt lds
    buffer_load_dwordx4 v5, s[20:23], s60 offen offset:1024 nt lds
    buffer_load_dwordx4 v6, s[20:23], s60 offen offset:2048 nt lds
    buffer_load_dwordx4 v7, s[20:23], s60 offen offset:3072 nt lds
    s_mov_b32 s53, 4
    s_sub_u32 s54, s54, 4
    s_branch L_prodone
L_slowpro:
    s_cmp_eq_u32 s51, 0
    s_cbranch_scc1 L_prodone
L_pro:
    s_add_u32 m0, s52, s53
    s_add_u32 s53, s53, 1
    s_movrels_b32 s60, s64
    s_lshl_b32 s60, s60, 14
    s_mov_b32 m0, s55
    s_sub_u32 s54, s54, 1
    buffer_load_dwordx4 v4, s[20:23], s60 offen offset:0 nt lds
    buffer_load_dwordx4 v5, s[20:23], s60 offen offset:1024 nt lds
    buffer_load_dwordx4 v6, s[20:23], s60 offen offset:2048 nt lds
    buffer_load_dwordx4 v7, s[20:23], s60 offen offset:3072 nt lds
    s_cmp_eq_u32 s53, s51
    s_cselect_b32 s53, 0, s53
    s_cselect_b32 s20, s8, s20
    s_cselect_b32 s21, s9, s21
    s_add_u32 s55, s55, 4096
    s_cmp_eq_u32 s54, 0
    s_cbranch_scc1 L_prodone
    s_cmp_lt_u32 s55, s58
    s_cbranch_scc1 L_pro
L_prodone:
    s_mov_b32 s28, s18
    s_mov_b32 s29, s19
    s_mov_b32 s30, 2162688
    s_mov_b32 s31, 0x00020000
    s_mov_b32 s36, s14
    s_mov_b32 s37, s15
    s_mov_b32 s38, 16384
    s_mov_b32 s39, 0x00020000
    v_mov_b32 v172, 0
    v_mov_b32 v173, 0
    s_min_i32 s49, s49, 0x8000
    s_add_u32 s63, s50, 1
    s_lshl_b32 s63, s63, 4
    s_mov_b32 s56, s57
    s_mov_b32 s62, 0x3e0293ee
    v_and_b32 v56, 7, v2
    v_lshrrev_b32 v57, 3, v2
    v_lshl_add_u32 v56, v56, 1, v57
    v_lshlrev_b32 v57, 2, v1
    v_xor_b32 v56, v56, v57
    v_lshlrev_b32 v56, 4, v56
    v_and_b32 v58, 3, v2
    v_lshrrev_b32 v59, 2, v2
    v_lshl_add_u32 v56, v58, 10, v56
    v_lshl_add_u32 v8, v59, 8, v56
    v_lshl_add_u32 v56, v59, 1, v3
    v_lshrrev_b32 v57, 1, v58
    v_xor_b32 v56, v56, v57
    v_lshlrev_b32 v56, 4, v56
    v_lshl_add_u32 v56, v59, 10, v56
    v_lshl_add_u32 v56, v1, 8, v56
    v_and_b32 v57, 1, v58
    v_lshl_add_u32 v9, v57, 3, v56
    s_mul_i32 s60, s3, 8768
    s_add_u32 s60, s60, 65552
    v_and_b32 v56, 7, v2
    v_lshl_add_u32 v57, v1, 3, v56
    v_lshlrev_b32 v57, 4, v57
    v_add_u32 v10, s60, v57
    v_lshrrev_b32 v57, 3, v2
    v_lshlrev_b32 v58, 3, v57
    v_sub_u32 v11, v10, v58
    v_lshl_add_u32 v12, v57, 9, v10
    v_mov_b32 v13, 0xff61b1e6
    v_mov_b32 v14, 0
    v_mov_b32 v64, 0
    v_mov_b32 v65, 0
    v_mov_b32 v66, 0
    v_mov_b32 v67, 0
    v_mov_b32 v68, 0
    v_mov_b32 v69, 0
    v_mov_b32 v70, 0
    v_mov_b32 v71, 0
    v_mov_b32 v72, 0
    v_mov_b32 v73, 0
    v_mov_b32 v74, 0
    v_mov_b32 v75, 0
    v_mov_b32 v76, 0
    v_mov_b32 v77, 0
    v_mov_b32 v78, 0
    v_mov_b32 v79, 0
    v_mov_b32 v56, s60
    v_subrev_u32 v56, 16, v56
    ds_write_b128 v56, v[64:67]
    v_and_b32 v175, 7, v2
    v_lshlrev_b32 v175, 4, v175
    s_and_b32 s60, s3, 1
    s_lshl_b32 s60, s60, 3
    s_add_u32 s60, s60, 100608
    v_add_u32 v175, s60, v175
    s_lshr_b32 s60, s3, 1
    s_lshl_b32 s60, s60, 2
    v_add_u32 v174, s60, v175
    v_and_b32 v56, 7, v0
    v_lshlrev_b32 v56, 4, v56
    v_bfe_u32 v57, v0, 3, 1
    v_lshl_add_u32 v56, v57, 3, v56
    v_add_u32 v176, 100608, v56
    v_lshlrev_b32 v56, 4, v0
    v_add_u32 v177, s57, v56
    s_xor_b32 s60, s3, 2
    s_mul_i32 s60, s60, 16384
    v_add_u32 v179, s60, v56
    v_add_u32 v189, 101008, v56
    s_lshl_b32 s60, s3, 2
    v_add_u32 v188, s60, v189
    s_and_b32 s60, s3, 1
    s_lshl_b32 s60, s60, 2
    s_add_u32 s60, s60, 100992
    v_mov_b32 v190, s60
    v_mov_b32 v191, 101000
    v_mov_b32 v144, 1
    v_mov_b32 v56, 100992
    ds_write_b128 v56, v[64:67]
    s_lshl_b32 s60, s82, 7
    s_add_u32 s60, s60, s81
    s_mul_i32 s60, s60, 8448
    s_add_u32 s61, s60, 8192
    v_lshl_add_u32 v183, v0, 4, s61
    s_and_b32 s61, s3, 1
    s_lshl_b32 s61, s61, 12
    s_add_u32 s60, s60, s61
    v_and_b32 v56, 1, v1
    v_lshrrev_b32 v57, 1, v1
    v_lshlrev_b32 v56, 11, v56
    v_lshl_add_u32 v56, v57, 10, v56
    v_lshl_add_u32 v56, v2, 4, v56
    v_add_u32 v182, s60, v56
    s_sub_u32 s60, 128, s44
    s_cmp_lt_u32 s2, 128
    s_cselect_b32 s100, s44, s60
    s_cselect_b32 s61, 0, s44
    s_lshr_b32 s60, s2, 6
    s_and_b32 s60, s60, 1
    s_lshl_b32 s60, s60, 7
    s_add_u32 s60, s60, s61
    s_mul_i32 s60, s60, 8448
    s_and_b32 s61, s2, 63
    s_lshl_b32 s61, s61, 7
    s_add_u32 s47, s60, s61
    s_lshr_b32 s61, s2, 4
    s_and_b32 s61, s61, 3
    s_lshl_b32 s61, s61, 6
    s_add_u32 s60, s60, s61
    s_add_u32 s46, s60, 8192
    v_lshrrev_b32 v56, 3, v0
    v_and_b32 v59, 7, v0
    v_and_b32 v57, 3, v0
    s_lshl_b32 s60, s3, 3
    v_add_u32 v56, s60, v56
    s_sub_u32 s101, s100, 1
    v_min_u32 v62, s101, v56
    v_mov_b32 v60, 0xff800000
    v_add_u32 v58, 0, v56
    v_cmp_gt_u32 vcc, s100, v58
    s_nop 1
    v_cndmask_b32 v58, v62, v58, vcc
    v_cndmask_b32 v136, v60, v181, vcc
    v_mul_u32_u24 v58, 8448, v58
    v_lshl_add_u32 v128, v57, 4, v58
    v_lshl_add_u32 v132, v59, 4, v58
    v_add_u32 v58, 32, v56
    v_cmp_gt_u32 vcc, s100, v58
    s_nop 1
    v_cndmask_b32 v58, v62, v58, vcc
    v_cndmask_b32 v137, v60, v181, vcc
    v_mul_u32_u24 v58, 8448, v58
    v_lshl_add_u32 v129, v57, 4, v58
    v_lshl_add_u32 v133, v59, 4, v58
    v_add_u32 v58, 64, v56
    v_cmp_gt_u32 vcc, s100, v58
    s_nop 1
    v_cndmask_b32 v58, v62, v58, vcc
    v_cndmask_b32 v138, v60, v181, vcc
    v_mul_u32_u24 v58, 8448, v58
    v_lshl_add_u32 v130, v57, 4, v58
    v_lshl_add_u32 v134, v59, 4, v58
    v_add_u32 v58, 96, v56
    v_cmp_gt_u32 vcc, s100, v58
    s_nop 1
    v_cndmask_b32 v58, v62, v58, vcc
    v_cndmask_b32 v139, v60, v181, vcc
    v_mul_u32_u24 v58, 8448, v58
    v_lshl_add_u32 v131, v57, 4, v58
    v_lshl_add_u32 v135, v59, 4, v58
    s_sub_i32 s101, s100, s60
    s_add_i32 s101, s101, 31
    s_ashr_i32 s101, s101, 5
    s_lshr_b32 s60, s2, 4
    s_lshl_b32 s60, s60, 10
    s_and_b32 s61, s2, 15
    s_lshl_b32 s61, s61, 4
    s_add_u32 s60, s60, s61
    v_lshlrev_b32 v58, 8, v1
    v_lshl_add_u32 v58, v59, 1, v58
    v_add_u32 v184, s60, v58
    v_mov_b32 v185, 0xff61b1e6
    v_lshlrev_b32 v58, 5, v57
    v_add_u32 v187, 100864, v58
    s_lshl_b32 s60, s3, 3
    v_add_u32 v186, s60, v187
    s_mov_b32 s48, 0xfffff000
    s_mov_b32 s59, s51
    s_mov_b32 s83, 0
    s_cmp_eq_u32 s51, 0
    s_cbranch_scc1 L_kdone2
L_k:
    v_add_u32 v56, s56, v8
    v_xor_b32 v57, 16, v56
    v_xor_b32 v58, 32, v56
    v_xor_b32 v59, 48, v56
    s_cmp_lt_u32 s51, 3
    s_cbranch_scc1 L_kw0
    s_waitcnt vmcnt(12)
L_kw1:
    ds_read_b128 v[32:35], v56
    ds_read_b128 v[36:39], v57
    ds_read_b128 v[40:43], v58
    ds_read_b128 v[44:47], v59
    s_cmp_eq_u32 s83, 0
    s_cbranch_scc1 L_ldnonce
L_ldnoncedone:
    s_waitcnt lgkmcnt(3)
    v_mfma_f32_16x16x32_bf16 v[48:51], v[32:35], v[16:19], 0
    s_waitcnt lgkmcnt(2)
    v_mfma_f32_16x16x32_bf16 v[48:51], v[36:39], v[20:23], v[48:51]
    s_waitcnt lgkmcnt(1)
    v_mfma_f32_16x16x32_bf16 v[48:51], v[40:43], v[24:27], v[48:51]
    s_waitcnt lgkmcnt(0)
    v_mfma_f32_16x16x32_bf16 v[48:51], v[44:47], v[28:31], v[48:51]
    s_cmp_eq_u32 s54, 0
    s_cbranch_scc1 L_knoissue
    s_add_u32 m0, s52, s53
    s_add_u32 s53, s53, 1
    s_movrels_b32 s60, s64
    s_lshl_b32 s60, s60, 14
    s_mov_b32 m0, s56
    s_sub_u32 s54, s54, 1
    buffer_load_dwordx4 v4, s[20:23], s60 offen offset:0 nt lds
    buffer_load_dwordx4 v5, s[20:23], s60 offen offset:1024 nt lds
    buffer_load_dwordx4 v6, s[20:23], s60 offen offset:2048 nt lds
    buffer_load_dwordx4 v7, s[20:23], s60 offen offset:3072 nt lds
    s_cmp_eq_u32 s53, s51
    s_cselect_b32 s53, 0, s53
    s_cselect_b32 s20, s8, s20
    s_cselect_b32 s21, s9, s21
L_knoissue:
    s_add_u32 s56, s56, 4096
    s_cmp_eq_u32 s56, s58
    s_cselect_b32 s56, s57, s56
    s_nop 4
    s_cmp_gt_i32 s63, s49
    s_cbranch_scc1 L_mask
L_maskdone:
    ds_write_b128 v10, v[48:51]
    v_max3_f32 v13, v13, v48, v49
    v_max3_f32 v13, v13, v50, v51
    v_add_u32 v10, 512, v10
    s_add_u32 s63, s63, 16
    s_sub_u32 s59, s59, 1
    s_cmp_lg_u32 s59, 0
    s_cbranch_scc1 L_k
    s_branch L_kdone2
L_kw0:
    s_waitcnt vmcnt(0)
    s_branch L_kw1
L_ldnonce:
    buffer_load_dwordx2 v[172:173], v181, s[32:35], 0 offen sc1
    s_mov_b32 s83, 1
    s_branch L_ldnoncedone
L_mask:
    s_cmp_le_i32 s49, 0
    s_cselect_b32 s60, 0, 0xff800000
    s_sub_u32 s61, s63, 16
    v_lshl_add_u32 v60, v1, 2, s61
    v_mov_b32 v61, s60
    v_add_u32 v62, 0, v60
    v_cmp_gt_i32 vcc, s49, v62
    s_nop 1
    v_cndmask_b32 v48, v61, v48, vcc
    v_add_u32 v62, 1, v60
    v_cmp_gt_i32 vcc, s49, v62
    s_nop 1
    v_cndmask_b32 v49, v61, v49, vcc
    v_add_u32 v62, 2, v60
    v_cmp_gt_i32 vcc, s49, v62
    s_nop 1
    v_cndmask_b32 v50, v61, v50, vcc
    v_add_u32 v62, 3, v60
    v_cmp_gt_i32 vcc, s49, v62
    s_nop 1
    v_cndmask_b32 v51, v61, v51, vcc
    s_branch L_maskdone
L_general:
    s_min_i32 s60, s40, 0x8000
    s_add_u32 s45, s60, 15
    s_lshr_b32 s45, s45, 4
    s_cmp_le_i32 s60, 0
    s_cselect_b32 s45, 0x800, s45
    s_min_i32 s60, s41, 0x8000
    s_add_u32 s46, s60, 15
    s_lshr_b32 s46, s46, 4
    s_cmp_le_i32 s60, 0
    s_cselect_b32 s46, 0x800, s46
    s_add_u32 s60, s45, s46
    v_cvt_f32_u32 v56, s60
    v_cvt_f32_u32 v57, s45
    v_rcp_f32 v56, v56
    v_mul_f32 v58, 0x43000000, v57
    v_fma_f32 v58, v58, v56, 0.5
    v_cvt_u32_f32 v58, v58
    s_add_u32 s60, s45, 31
    v_readfirstlane_b32 s44, v58
    s_lshr_b32 s60, s60, 5
    s_add_u32 s61, s46, 31
    s_lshr_b32 s61, s61, 5
    s_sub_u32 s61, 128, s61
    s_max_u32 s44, s44, s60
    s_min_u32 s44, s44, s61
    s_sub_u32 s60, 128, s44
    v_cvt_f32_u32 v56, s44
    v_cvt_f32_u32 v58, s60
    v_cvt_f32_u32 v59, s46
    v_rcp_f32 v56, v56
    v_rcp_f32 v58, v58
    v_add_f32 v57, 0x3e800000, v57
    v_add_f32 v59, 0x3e800000, v59
    v_mul_f32 v57, 0x47000000, v57
    v_mul_f32 v59, 0x47000000, v59
    v_mul_f32 v57, v57, v56
    v_mul_f32 v59, v59, v58
    v_cvt_u32_f32 v57, v57
    v_cvt_u32_f32 v59, v59
    s_nop 0
    v_readfirstlane_b32 s42, v57
    v_readfirstlane_b32 s43, v59
    s_nop 1
    s_mov_b64 s[98:99], s[40:41]
    s_branch L_ranges
L_nonceslow:
    s_sub_u32 s83, s83, 1
    s_cbranch_scc1 L_nonceok
    buffer_load_dwordx2 v[172:173], v181, s[32:35], 0 offen sc1
    s_waitcnt vmcnt(0)
    s_branch L_noncechk
L_kdone2:
    v_mov_b32 v56, 0xff800000
    v_mov_b32 v57, 0xff800000
    v_mov_b32 v58, 0xff800000
    v_mov_b32 v59, 0xff800000
    ds_write_b128 v10, v[56:59]
    v_mov_b32 v60, v13
    s_nop 1
    v_permlane16_swap_b32 v13, v60
    v_max_f32 v13, v13, v60
    v_mov_b32 v60, v13
    s_nop 1
    v_permlane32_swap_b32 v13, v60
    v_max_f32 v13, v13, v60
    v_mul_f32 v13, s62, v13
    ds_write_b32 v174, v13
    s_mov_b32 s83, 1048576
L_noncechk:
    v_readfirstlane_b32 s40, v172
    v_readfirstlane_b32 s41, v173
    s_nop 1
    s_min_u32 s60, s40, s41
    s_cmp_eq_u32 s60, 0
    s_cbranch_scc1 L_nonceslow
L_nonceok:
    s_waitcnt lgkmcnt(0)
    s_barrier
    ds_read_b64 v[56:57], v175
    ds_read_b128 v[60:63], v12
    v_mov_b32 v54, 0
    v_mov_b32 v55, 0
    s_mov_b32 s61, 0x9E3779B1
    s_mul_i32 s42, s40, s61
    s_mul_hi_u32 s43, s40, s61
    s_mul_i32 s60, s41, s61
    s_add_u32 s43, s43, s60
    s_lshr_b64 s[42:43], s[42:43], 1
    s_and_b32 s60, s42, 0x7ff
    v_mov_b32 v148, s60
    s_bfe_u32 s60, s42, 0xb000b
    v_mov_b32 v149, s60
    s_lshr_b64 s[42:43], s[42:43], 22
    s_and_b32 s60, s42, 0x7ff
    v_mov_b32 v150, s60
    s_bfe_u32 s60, s42, 0xb000b
    v_mov_b32 v151, s60
    v_or_b32 v152, 0x800, v148
    v_or_b32 v153, 0x800, v149
    v_or_b32 v154, 0x800, v150
    v_or_b32 v155, 0x800, v151
    s_add_u32 s59, s51, 1
    s_lshr_b32 s59, s59, 1
    s_waitcnt lgkmcnt(1)
    v_max_f32 v13, v56, v57
    v_sub_f32 v15, 0, v13
    s_cmp_eq_u32 s59, 0
    s_cbranch_scc1 L_pdone
L_p:
    s_waitcnt lgkmcnt(0)
    v_fma_f32 v56, v60, s62, v15
    v_fma_f32 v57, v61, s62, v15
    v_fma_f32 v58, v62, s62, v15
    v_fma_f32 v59, v63, s62, v15
    ds_read_b128 v[60:63], v12 offset:1024
    v_exp_f32 v56, v56
    v_exp_f32 v57, v57
    v_exp_f32 v58, v58
    v_exp_f32 v59, v59
    s_nop 0
    v_cvt_pk_bf16_f32 v52, v56, v57
    v_cvt_pk_bf16_f32 v53, v58, v59
    v_add_f32 v56, v56, v57
    v_add_f32 v58, v58, v59
    ds_write_b128 v12, v[52:55]
    v_add_f32 v14, v14, v56
    v_add_u32 v12, 1024, v12
    v_add_f32 v14, v14, v58
    s_sub_u32 s59, s59, 1
    s_cmp_lg_u32 s59, 0
    s_cbranch_scc1 L_p
L_pdone:
    s_waitcnt lgkmcnt(0)
    s_nop 0
    v_add_f32_dpp v14, v14, v14 row_ror:8 row_mask:0xf bank_mask:0xf
    v_mov_b32 v60, v14
    s_nop 1
    v_permlane16_swap_b32 v14, v60
    v_add_f32 v14, v14, v60
    v_mov_b32 v60, v14
    s_nop 1
    v_permlane32_swap_b32 v14, v60
    v_add_f32 v14, v14, v60
    ds_write_b32 v174, v14 offset:128
    s_waitcnt lgkmcnt(0)
    s_barrier
    s_cmp_lg_u32 s3, 0
    s_cbranch_scc1 L_mldone
    ds_read_b64 v[56:57], v176
    ds_read_b64 v[58:59], v176 offset:128
    s_waitcnt lgkmcnt(0)
    v_max_f32 v56, v56, v57
    v_add_f32 v57, v58, v59
    v_xor_b32 v58, s40, v56
    v_xor_b32 v59, s41, v57
    s_mov_b64 exec, 0xffff
    buffer_store_dwordx4 v[56:59], v183, s[28:31], 0 offen sc1
    s_mov_b64 exec, -1
    s_nop 1
L_mldone:
    s_cmp_eq_u32 s51, 0
    s_cbranch_scc1 L_vnone
    s_sub_u32 s59, s51, 1
L_v:
    ds_read2_b64 v[52:55], v11 offset0:0 offset1:1
    v_add_u32 v56, s56, v9
    v_xor_b32 v57, 32, v56
    v_xor_b32 v58, 64, v56
    v_xor_b32 v59, 96, v56
    v_xor_b32 v60, 128, v56
    v_xor_b32 v61, 160, v56
    v_xor_b32 v62, 192, v56
    v_xor_b32 v63, 224, v56
    v_add_u32 v11, 512, v11
    s_cmp_eq_u32 s59, 0
    s_cbranch_scc1 L_vlast
    s_cmp_ge_u32 s59, 3
    s_cbranch_scc1 L_vw3
    s_cmp_ge_u32 s59, 2
    s_cbranch_scc1 L_vw2
    buffer_load_dwordx4 v[96:99], v128, s[28:31], s46 offen sc1
    buffer_load_dwordx4 v[100:103], v129, s[28:31], s46 offen sc1
    buffer_load_dwordx4 v[104:107], v130, s[28:31], s46 offen sc1
    buffer_load_dwordx4 v[108:111], v131, s[28:31], s46 offen sc1
    s_mov_b32 s83, 0
    s_waitcnt vmcnt(8)
L_vgo:
    ds_read_b64_tr_b16 v[32:33], v56
    ds_read_b64_tr_b16 v[34:35], v60
    ds_read_b64_tr_b16 v[36:37], v57
    ds_read_b64_tr_b16 v[38:39], v61
    ds_read_b64_tr_b16 v[40:41], v58
    ds_read_b64_tr_b16 v[42:43], v62
    ds_read_b64_tr_b16 v[44:45], v59
    ds_read_b64_tr_b16 v[46:47], v63
    s_waitcnt lgkmcnt(6)
    v_mfma_f32_16x16x32_bf16 v[64:67], v[52:55], v[32:35], v[64:67]
    s_waitcnt lgkmcnt(4)
    v_mfma_f32_16x16x32_bf16 v[68:71], v[52:55], v[36:39], v[68:71]
    s_waitcnt lgkmcnt(2)
    v_mfma_f32_16x16x32_bf16 v[72:75], v[52:55], v[40:43], v[72:75]
    s_waitcnt lgkmcnt(0)
    v_mfma_f32_16x16x32_bf16 v[76:79], v[52:55], v[44:47], v[76:79]
    s_cmp_eq_u32 s54, 0
    s_cbranch_scc1 L_vnoissue
    s_add_u32 m0, s52, s53
    s_add_u32 s53, s53, 1
    s_movrels_b32 s60, s64
    s_lshl_b32 s60, s60, 14
    s_mov_b32 m0, s56
    s_sub_u32 s54, s54, 1
    buffer_load_dwordx4 v4, s[20:23], s60 offen offset:0 nt lds
    buffer_load_dwordx4 v5, s[20:23], s60 offen offset:1024 nt lds
    buffer_load_dwordx4 v6, s[20:23], s60 offen offset:2048 nt lds
    buffer_load_dwordx4 v7, s[20:23], s60 offen offset:3072 nt lds
    s_cmp_eq_u32 s53, s51
    s_cselect_b32 s53, 0, s53
    s_cselect_b32 s20, s8, s20
    s_cselect_b32 s21, s9, s21
L_vnoissue:
    s_add_u32 s56, s56, 4096
    s_cmp_eq_u32 s56, s58
    s_cselect_b32 s56, s57, s56
    s_sub_u32 s59, s59, 1
    s_branch L_v
L_vw3:
    s_waitcnt vmcnt(12)
    s_branch L_vgo
L_vw2:
    s_waitcnt vmcnt(8)
    s_branch L_vgo
L_vnone:
    buffer_load_dwordx4 v[96:99], v128, s[28:31], s46 offen sc1
    buffer_load_dwordx4 v[100:103], v129, s[28:31], s46 offen sc1
    buffer_load_dwordx4 v[104:107], v130, s[28:31], s46 offen sc1
    buffer_load_dwordx4 v[108:111], v131, s[28:31], s46 offen sc1
    s_branch L_pdep
L_vml1:
    buffer_load_dwordx4 v[96:99], v128, s[28:31], s46 offen sc1
    buffer_load_dwordx4 v[100:103], v129, s[28:31], s46 offen sc1
    buffer_load_dwordx4 v[104:107], v130, s[28:31], s46 offen sc1
    buffer_load_dwordx4 v[108:111], v131, s[28:31], s46 offen sc1
    s_branch L_vl2
L_vlast:
    s_cmp_eq_u32 s51, 1
    s_cbranch_scc1 L_vml1
L_vl2:
    s_waitcnt vmcnt(4)
    ds_read_b64_tr_b16 v[32:33], v56
    ds_read_b64_tr_b16 v[34:35], v60
    ds_read_b64_tr_b16 v[36:37], v57
    ds_read_b64_tr_b16 v[38:39], v61
    ds_read_b64_tr_b16 v[40:41], v58
    ds_read_b64_tr_b16 v[42:43], v62
    ds_read_b64_tr_b16 v[44:45], v59
    ds_read_b64_tr_b16 v[46:47], v63
    ds_read_b32 v156, v190
    ds_read_b128 v[208:211], v179 offset:0
    ds_read_b128 v[212:215], v179 offset:1024
    ds_read_b128 v[216:219], v179 offset:2048
    ds_read_b128 v[220:223], v179 offset:3072
    s_waitcnt lgkmcnt(11)
    v_mfma_f32_16x16x32_bf16 v[64:67], v[52:55], v[32:35], v[64:67]
    s_waitcnt lgkmcnt(9)
    v_mfma_f32_16x16x32_bf16 v[68:71], v[52:55], v[36:39], v[68:71]
    s_waitcnt lgkmcnt(7)
    v_mfma_f32_16x16x32_bf16 v[72:75], v[52:55], v[40:43], v[72:75]
    s_waitcnt lgkmcnt(5)
    v_mfma_f32_16x16x32_bf16 v[76:79], v[52:55], v[44:47], v[76:79]
    s_waitcnt lgkmcnt(4)
    v_readfirstlane_b32 s60, v156
    s_nop 1
    s_cmp_eq_u32 s60, 0
    s_cbranch_scc1 L_pdep0
L_ppub:
    s_waitcnt lgkmcnt(3)
    v_pk_add_f32 v[64:65], v[64:65], v[208:209]
    v_pk_add_f32 v[66:67], v[66:67], v[210:211]
    v_and_or_b32 v64, v64, s48, v152
    v_and_or_b32 v65, v65, s48, v153
    v_and_or_b32 v66, v66, s48, v154
    v_and_or_b32 v67, v67, s48, v155
    buffer_store_dwordx4 v[64:67], v182, s[28:31], 0 offen offset:0 sc1
    s_waitcnt lgkmcnt(2)
    v_pk_add_f32 v[68:69], v[68:69], v[212:213]
    v_pk_add_f32 v[70:71], v[70:71], v[214:215]
    v_and_or_b32 v68, v68, s48, v152
    v_and_or_b32 v69, v69, s48, v153
    v_and_or_b32 v70, v70, s48, v154
    v_and_or_b32 v71, v71, s48, v155
    buffer_store_dwordx4 v[68:71], v182, s[28:31], 0 offen offset:256 sc1
    s_waitcnt lgkmcnt(1)
    v_pk_add_f32 v[72:73], v[72:73], v[216:217]
    v_pk_add_f32 v[74:75], v[74:75], v[218:219]
    v_and_or_b32 v72, v72, s48, v152
    v_and_or_b32 v73, v73, s48, v153
    v_and_or_b32 v74, v74, s48, v154
    v_and_or_b32 v75, v75, s48, v155
    buffer_store_dwordx4 v[72:75], v182, s[28:31], 0 offen offset:512 sc1
    s_waitcnt lgkmcnt(0)
    v_pk_add_f32 v[76:77], v[76:77], v[220:221]
    v_pk_add_f32 v[78:79], v[78:79], v[222:223]
    v_and_or_b32 v76, v76, s48, v152
    v_and_or_b32 v77, v77, s48, v153
    v_and_or_b32 v78, v78, s48, v154
    v_and_or_b32 v79, v79, s48, v155
    buffer_store_dwordx4 v[76:79], v182, s[28:31], 0 offen offset:768 sc1
    s_waitcnt vmcnt(4)
    s_branch L_pjoin
L_pdep0:
    s_nop 2
L_pdep:
    ds_write_b128 v177, v[64:67] offset:0
    ds_write_b128 v177, v[68:71] offset:1024
    ds_write_b128 v177, v[72:75] offset:2048
    ds_write_b128 v177, v[76:79] offset:3072
    s_mov_b64 exec, 1
    ds_add_rtn_u32 v156, v190, v144
    s_mov_b64 exec, -1
    ds_read_b128 v[208:211], v179 offset:0
    ds_read_b128 v[212:215], v179 offset:1024
    ds_read_b128 v[216:219], v179 offset:2048
    ds_read_b128 v[220:223], v179 offset:3072
    s_waitcnt lgkmcnt(4)
    v_readfirstlane_b32 s60, v156
    s_nop 1
    s_cmp_lg_u32 s60, 0
    s_cbranch_scc1 L_ppub
    s_waitcnt vmcnt(0) lgkmcnt(0)
L_pjoin:
    s_mov_b32 s58, 1048576
    s_cmp_eq_u32 s3, 0
    s_cselect_b64 s[64:65], -1, 0
    s_cmp_eq_u32 s3, 1
    s_cselect_b64 s[66:67], -1, 0
    s_cmp_eq_u32 s3, 2
    s_cselect_b64 s[68:69], -1, 0
    s_cmp_eq_u32 s3, 3
    s_cselect_b64 s[70:71], -1, 0
L_mlchk:
    v_xor_b32 v156, s40, v98
    v_xor_b32 v157, s41, v99
    v_xor_b32 v156, v156, v96
    v_xor_b32 v157, v157, v97
    v_xor_b32 v158, s40, v102
    v_xor_b32 v159, s41, v103
    v_xor_b32 v158, v158, v100
    v_xor_b32 v159, v159, v101
    v_xor_b32 v160, s40, v106
    v_xor_b32 v161, s41, v107
    v_xor_b32 v160, v160, v104
    v_xor_b32 v161, v161, v105
    v_xor_b32 v162, s40, v110
    v_xor_b32 v163, s41, v111
    v_xor_b32 v162, v162, v108
    v_xor_b32 v163, v163, v109
    v_or3_b32 v156, v156, v157, v158
    v_or3_b32 v156, v156, v159, v160
    v_or3_b32 v156, v156, v161, v162
    v_or_b32 v156, v156, v163
    v_cmp_ne_u32 vcc, 0, v156
    s_cbranch_vccz L_mlok
    s_sub_u32 s58, s58, 1
    s_cmp_lt_i32 s58, 0
    s_cbranch_scc1 L_mlok
    s_mov_b64 exec, vcc
    buffer_load_dwordx4 v[96:99], v128, s[28:31], s46 offen sc1
    buffer_load_dwordx4 v[100:103], v129, s[28:31], s46 offen sc1
    buffer_load_dwordx4 v[104:107], v130, s[28:31], s46 offen sc1
    buffer_load_dwordx4 v[108:111], v131, s[28:31], s46 offen sc1
    s_mov_b64 exec, -1
    s_waitcnt vmcnt(0)
    s_branch L_mlchk
L_mlok:
    v_add_f32 v140, v96, v136
    v_add_f32 v141, v100, v137
    v_add_f32 v142, v104, v138
    v_add_f32 v143, v108, v139
    v_max3_f32 v156, v185, v140, v141
    v_max3_f32 v156, v156, v142, v143
    s_nop 1
    v_max_f32_dpp v156, v156, v156 row_ror:8 row_mask:0xf bank_mask:0xf
    v_mov_b32 v158, v156
    s_nop 1
    v_permlane16_swap_b32 v156, v158
    v_max_f32 v156, v156, v158
    v_mov_b32 v158, v156
    s_nop 1
    v_permlane32_swap_b32 v156, v158
    v_max_f32 v156, v156, v158
    v_sub_f32 v140, v140, v156
    v_sub_f32 v141, v141, v156
    v_sub_f32 v142, v142, v156
    v_sub_f32 v143, v143, v156
    v_exp_f32 v140, v140
    v_exp_f32 v141, v141
    v_exp_f32 v142, v142
    v_exp_f32 v143, v143
    v_mul_f32 v157, v140, v97
    v_fmac_f32 v157, v141, v101
    v_fmac_f32 v157, v142, v105
    v_fmac_f32 v157, v143, v109
    s_nop 1
    v_add_f32_dpp v157, v157, v157 row_ror:8 row_mask:0xf bank_mask:0xf
    v_mov_b32 v158, v157
    s_nop 1
    v_permlane16_swap_b32 v157, v158
    v_add_f32 v157, v157, v158
    v_mov_b32 v158, v157
    s_nop 1
    v_permlane32_swap_b32 v157, v158
    v_add_f32 v157, v157, v158
    ds_write_b64 v186, v[156:157]
    s_waitcnt lgkmcnt(0)
    s_barrier
    ds_read_b128 v[160:163], v187
    ds_read_b128 v[164:167], v187 offset:16
    s_waitcnt lgkmcnt(0)
    v_max3_f32 v158, v160, v162, v164
    v_max_f32 v158, v158, v166
    v_sub_f32 v160, v160, v158
    v_sub_f32 v162, v162, v158
    v_sub_f32 v164, v164, v158
    v_sub_f32 v166, v166, v158
    v_sub_f32 v156, v156, v158
    v_exp_f32 v160, v160
    v_exp_f32 v162, v162
    v_exp_f32 v164, v164
    v_exp_f32 v166, v166
    v_exp_f32 v156, v156
    v_mul_f32 v158, v160, v161
    v_fmac_f32 v158, v162, v163
    v_fmac_f32 v158, v164, v165
    v_fmac_f32 v158, v166, v167
    v_rcp_f32 v158, v158
    s_nop 0
    v_mul_f32 v156, v156, v158
    v_mul_f32 v140, v140, v156
    v_mul_f32 v141, v141, v156
    v_mul_f32 v142, v142, v156
    v_mul_f32 v143, v143, v156
    s_nop 1
    v_mov_b32_dpp v192, v140 quad_perm:[0,0,0,0] row_mask:0xf bank_mask:0xf
    v_mov_b32_dpp v193, v140 quad_perm:[1,1,1,1] row_mask:0xf bank_mask:0xf
    v_mov_b32_dpp v194, v140 quad_perm:[2,2,2,2] row_mask:0xf bank_mask:0xf
    v_mov_b32_dpp v195, v140 quad_perm:[3,3,3,3] row_mask:0xf bank_mask:0xf
    v_mov_b32_dpp v196, v141 quad_perm:[0,0,0,0] row_mask:0xf bank_mask:0xf
    v_mov_b32_dpp v197, v141 quad_perm:[1,1,1,1] row_mask:0xf bank_mask:0xf
    v_mov_b32_dpp v198, v141 quad_perm:[2,2,2,2] row_mask:0xf bank_mask:0xf
    v_mov_b32_dpp v199, v141 quad_perm:[3,3,3,3] row_mask:0xf bank_mask:0xf
    v_mov_b32_dpp v200, v142 quad_perm:[0,0,0,0] row_mask:0xf bank_mask:0xf
    v_mov_b32_dpp v201, v142 quad_perm:[1,1,1,1] row_mask:0xf bank_mask:0xf
    v_mov_b32_dpp v202, v142 quad_perm:[2,2,2,2] row_mask:0xf bank_mask:0xf
    v_mov_b32_dpp v203, v142 quad_perm:[3,3,3,3] row_mask:0xf bank_mask:0xf
    v_mov_b32_dpp v204, v143 quad_perm:[0,0,0,0] row_mask:0xf bank_mask:0xf
    v_mov_b32_dpp v205, v143 quad_perm:[1,1,1,1] row_mask:0xf bank_mask:0xf
    v_mov_b32_dpp v206, v143 quad_perm:[2,2,2,2] row_mask:0xf bank_mask:0xf
    v_mov_b32_dpp v207, v143 quad_perm:[3,3,3,3] row_mask:0xf bank_mask:0xf
    s_cmp_le_i32 s101, 2
    s_cbranch_scc1 L_c2
    s_cmp_eq_u32 s101, 3
    s_cbranch_scc1 L_c3
L_c4:
    s_mov_b64 vcc, -1
L_poll4:
    s_mov_b64 exec, vcc
    buffer_load_dwordx4 v[80:83], v132, s[28:31], s47 offen sc1
    buffer_load_dwordx4 v[84:87], v133, s[28:31], s47 offen sc1
    buffer_load_dwordx4 v[88:91], v134, s[28:31], s47 offen sc1
    buffer_load_dwordx4 v[92:95], v135, s[28:31], s47 offen sc1
    s_mov_b64 exec, -1
    s_sub_u32 s58, s58, 1
    s_cmp_lt_i32 s58, 0
    s_cbranch_scc1 L_to4
    s_waitcnt vmcnt(0)
    ds_read_b32 v164, v191
    ds_read_b128 v[160:163], v189
    v_xor_b32 v112, v80, v148
    v_xor_b32 v113, v81, v149
    v_xor_b32 v114, v82, v150
    v_xor_b32 v115, v83, v151
    v_xor_b32 v116, v84, v148
    v_xor_b32 v117, v85, v149
    v_xor_b32 v118, v86, v150
    v_xor_b32 v119, v87, v151
    v_xor_b32 v120, v88, v148
    v_xor_b32 v121, v89, v149
    v_xor_b32 v122, v90, v150
    v_xor_b32 v123, v91, v151
    v_xor_b32 v124, v92, v148
    v_xor_b32 v125, v93, v149
    v_xor_b32 v126, v94, v150
    v_xor_b32 v127, v95, v151
    v_or3_b32 v156, v112, v113, v114
    v_or3_b32 v156, v156, v115, v116
    v_or3_b32 v156, v156, v117, v118
    v_or3_b32 v156, v156, v119, v120
    v_or3_b32 v156, v156, v121, v122
    v_or3_b32 v156, v156, v123, v124
    v_or3_b32 v156, v156, v125, v126
    v_or_b32 v156, v156, v127
    v_and_b32 v156, 0x7ff, v156
    v_cmp_ne_u32 vcc, 0, v156
    s_cbranch_vccnz L_poll4
L_to4:
    v_pk_mul_f32 v[156:157], v[112:113], v[192:193]
    v_pk_mul_f32 v[158:159], v[114:115], v[194:195]
    v_pk_fma_f32 v[156:157], v[116:117], v[196:197], v[156:157]
    v_pk_fma_f32 v[158:159], v[118:119], v[198:199], v[158:159]
    v_pk_fma_f32 v[156:157], v[120:121], v[200:201], v[156:157]
    v_pk_fma_f32 v[158:159], v[122:123], v[202:203], v[158:159]
    v_pk_fma_f32 v[156:157], v[124:125], v[204:205], v[156:157]
    v_pk_fma_f32 v[158:159], v[126:127], v[206:207], v[158:159]
    s_branch L_rest
L_c3:
    s_mov_b64 vcc, -1
L_poll3:
    s_mov_b64 exec, vcc
    buffer_load_dwordx4 v[80:83], v132, s[28:31], s47 offen sc1
    buffer_load_dwordx4 v[84:87], v133, s[28:31], s47 offen sc1
    buffer_load_dwordx4 v[88:91], v134, s[28:31], s47 offen sc1
    s_mov_b64 exec, -1
    s_sub_u32 s58, s58, 1
    s_cmp_lt_i32 s58, 0
    s_cbranch_scc1 L_to3
    s_waitcnt vmcnt(0)
    ds_read_b32 v164, v191
    ds_read_b128 v[160:163], v189
    v_xor_b32 v112, v80, v148
    v_xor_b32 v113, v81, v149
    v_xor_b32 v114, v82, v150
    v_xor_b32 v115, v83, v151
    v_xor_b32 v116, v84, v148
    v_xor_b32 v117, v85, v149
    v_xor_b32 v118, v86, v150
    v_xor_b32 v119, v87, v151
    v_xor_b32 v120, v88, v148
    v_xor_b32 v121, v89, v149
    v_xor_b32 v122, v90, v150
    v_xor_b32 v123, v91, v151
    v_or3_b32 v156, v112, v113, v114
    v_or3_b32 v156, v156, v115, v116
    v_or3_b32 v156, v156, v117, v118
    v_or3_b32 v156, v156, v119, v120
    v_or3_b32 v156, v156, v121, v122
    v_or_b32 v156, v156, v123
    v_and_b32 v156, 0x7ff, v156
    v_cmp_ne_u32 vcc, 0, v156
    s_cbranch_vccnz L_poll3
L_to3:
    v_pk_mul_f32 v[156:157], v[112:113], v[192:193]
    v_pk_mul_f32 v[158:159], v[114:115], v[194:195]
    v_pk_fma_f32 v[156:157], v[116:117], v[196:197], v[156:157]
    v_pk_fma_f32 v[158:159], v[118:119], v[198:199], v[158:159]
    v_pk_fma_f32 v[156:157], v[120:121], v[200:201], v[156:157]
    v_pk_fma_f32 v[158:159], v[122:123], v[202:203], v[158:159]
    s_branch L_rest
L_c2:
    s_mov_b64 vcc, -1
L_poll2:
    s_mov_b64 exec, vcc
    buffer_load_dwordx4 v[80:83], v132, s[28:31], s47 offen sc1
    buffer_load_dwordx4 v[84:87], v133, s[28:31], s47 offen sc1
    s_mov_b64 exec, -1
    s_sub_u32 s58, s58, 1
    s_cmp_lt_i32 s58, 0
    s_cbranch_scc1 L_to2
    s_waitcnt vmcnt(0)
    ds_read_b32 v164, v191
    ds_read_b128 v[160:163], v189
    v_xor_b32 v112, v80, v148
    v_xor_b32 v113, v81, v149
    v_xor_b32 v114, v82, v150
    v_xor_b32 v115, v83, v151
    v_xor_b32 v116, v84, v148
    v_xor_b32 v117, v85, v149
    v_xor_b32 v118, v86, v150
    v_xor_b32 v119, v87, v151
    v_or3_b32 v156, v112, v113, v114
    v_or3_b32 v156, v156, v115, v116
    v_or3_b32 v156, v156, v117, v118
    v_or_b32 v156, v156, v119
    v_and_b32 v156, 0x7ff, v156
    v_cmp_ne_u32 vcc, 0, v156
    s_cbranch_vccnz L_poll2
L_to2:
    v_pk_mul_f32 v[156:157], v[112:113], v[192:193]
    v_pk_mul_f32 v[158:159], v[114:115], v[194:195]
    v_pk_fma_f32 v[156:157], v[116:117], v[196:197], v[156:157]
    v_pk_fma_f32 v[158:159], v[118:119], v[198:199], v[158:159]
L_rest:
    s_waitcnt lgkmcnt(0)
    v_readfirstlane_b32 s60, v164
    v_permlane32_swap_b32 v156, v158
    v_permlane32_swap_b32 v157, v159
    v_pk_add_f32 v[156:157], v[156:157], v[158:159]
    s_nop 1
    v_permlane16_swap_b32 v156, v157
    v_add_f32 v156, v156, v157
    s_cmp_eq_u32 s60, 3
    s_cbranch_scc0 L_dep
L_merge:
    v_cndmask_b32 v160, v160, v156, s[64:65]
    v_cndmask_b32 v161, v161, v156, s[66:67]
    v_cndmask_b32 v162, v162, v156, s[68:69]
    v_cndmask_b32 v163, v163, v156, s[70:71]
    v_pk_add_f32 v[160:161], v[160:161], v[162:163]
    v_add_f32 v156, v160, v161
    s_mov_b32 s60, 0x00010001
    s_nop 0
    v_add_f32_dpp v156, v156, v156 row_ror:8 row_mask:0xf bank_mask:0xf
    s_nop 1
    v_mov_b32_dpp v157, v156 quad_perm:[1,1,3,3] row_mask:0xf bank_mask:0xf
    v_cvt_pk_bf16_f32 v160, v156, v157
    s_nop 1
    v_mov_b32_dpp v161, v160 row_shl:2 row_mask:0xf bank_mask:0xf
    v_mov_b32_dpp v162, v160 row_shl:4 row_mask:0xf bank_mask:0xf
    v_mov_b32_dpp v163, v160 row_shl:6 row_mask:0xf bank_mask:0xf
    s_mov_b32 exec_lo, s60
    s_mov_b32 exec_hi, s60
    buffer_store_dwordx4 v[160:163], v184, s[36:39], 0 offen sc1
    s_mov_b64 exec, -1
    s_branch L_fin
L_dep:
    ds_write_b32 v188, v156
    s_mov_b64 exec, 1
    ds_add_rtn_u32 v164, v191, v144
    s_mov_b64 exec, -1
    ds_read_b128 v[160:163], v189
    s_waitcnt lgkmcnt(0)
    v_readfirstlane_b32 s60, v164
    s_nop 1
    s_cmp_eq_u32 s60, 3
    s_cbranch_scc1 L_merge
L_fin:
L_end:
    s_endpgm
.section .rodata,"a"
.p2align 6
.amdhsa_kernel standalone__paged_block_table_kv_pagedattention__decode_kernel
  .amdhsa_next_free_vgpr 224
  .amdhsa_next_free_sgpr 102
  .amdhsa_accum_offset 224
  .amdhsa_group_segment_fixed_size 0
  .amdhsa_kernarg_size 64
  .amdhsa_user_sgpr_count 2
  .amdhsa_user_sgpr_kernarg_segment_ptr 1
  .amdhsa_system_sgpr_workgroup_id_x 1
.end_amdhsa_kernel
```
